```python
import torch

def _softmax(x, axis=-1):
    return torch.softmax(x, dim=axis)
def _gelu(x):
    return torch.nn.functional.gelu(x, approximate="tanh")
def _silu(x):
    return torch.nn.functional.silu(x)
def _sigmoid(x):
    return torch.sigmoid(x)
def _layernorm(x, axis=-1, eps=1e-5):
    m = x.mean(dim=axis, keepdim=True)
    v = x.var(dim=axis, keepdim=True, unbiased=False)
    return (x - m) / torch.sqrt(v + eps)
def _scatter_add(tgt, idx, src, axis=0):
    return tgt.clone().index_add_(axis, idx, src)
def _segment_sum(src, seg, n):
    out = torch.zeros((n,) + src.shape[1:], dtype=src.dtype)
    return out.index_add_(0, seg, src)
def _pad(x, pw):
    flat = tuple(v for pair in reversed(pw) for v in pair)
    return torch.nn.functional.pad(x, flat)

kernel_name = 'standalone__gqa_softmax__decode'

def setup_inputs():

    _w = (lambda a: (lambda t: t.to(torch.bfloat16) if t.is_floating_point() else t)(torch.as_tensor(a)))
    B, Hq, Hkv, Sq, Sk, D = 2, 32, 16, 1, 8192, 128
    return {
        "q": _w((lambda *s: torch.randn(*s, dtype=torch.bfloat16) * 0.8)(B, Hq, Sq, D)),
        "k": _w((lambda *s: torch.randn(*s, dtype=torch.bfloat16) * 0.8)(B, Hkv, Sk, D)),
        "v": _w((lambda *s: torch.randn(*s, dtype=torch.bfloat16) * 0.05)(B, Hkv, Sk, D)),
    }

def reference(q, k, v):
    B, Hq, Sq, D = q.shape
    Hkv = k.shape[1]
    rep = Hq // Hkv
    k = (lambda x, n, axis: torch.repeat_interleave(x, n, dim=axis))(k, rep, axis=1)
    v = (lambda x, n, axis: torch.repeat_interleave(x, n, dim=axis))(v, rep, axis=1)
    scale = D ** -0.5
    scores = torch.einsum("bhqd,bhkd->bhqk", q, k) * scale
    p = _softmax(scores, axis=-1)
    return torch.einsum("bhqk,bhkd->bhqd", p, v)
```

```asm
; @launch grid=(256,1,1) block=(320,1,1) lds=84000
.amdgcn_target "amdgcn-amd-amdhsa--gfx950"
.text
.globl standalone__gqa_softmax__decode_kernel
.p2align 8
.type standalone__gqa_softmax__decode_kernel,@function
standalone__gqa_softmax__decode_kernel:
    s_load_dwordx2 s[8:9], s[0:1], 8
    s_load_dwordx2 s[4:5], s[0:1], 0
    v_readfirstlane_b32 s20, v0
    s_lshr_b32 s28, s2, 3
    s_and_b32 s21, s2, 7
    s_lshl_b32 s21, s21, 5
    s_or_b32 s21, s21, s28
    s_cmp_ge_u32 s28, 32
    s_cbranch_scc1 L_end
    s_lshl_b32 s21, s21, 18
    v_and_b32 v9, 0x1cc, v0
    v_and_b32 v4, 48, v0
    v_and_b32 v5, 3, v0
    v_lshlrev_b32 v5, 4, v5
    v_lshl_or_b32 v4, v4, 2, v5
    v_lshl_or_b32 v9, v9, 6, v4
    v_add_u32 v9, s21, v9
    s_add_u32 s10, s21, 0x40000
    s_mov_b32 s11, 0x20000
    s_movk_i32 s30, 16384
    s_lshr_b32 s19, s21, 12
    s_andn2_b32 s19, s19, 0x1ff
    v_bfe_u32 v5, v0, 3, 1
    v_lshl_add_u32 v4, v5, 8, v4
    v_add_u32 v4, s19, v4
    s_bitcmp1_b32 s20, 8
    s_cbranch_scc1 L_helper
    s_waitcnt lgkmcnt(0)
    global_load_dwordx4 v[28:31], v4, s[4:5]
    buffer_load_dwordx4 v[88:91], v9, s[8:11], 0 offen offset:0 nt
    buffer_load_dwordx4 v[92:95], v9, s[8:11], 0 offen offset:1024 nt
    buffer_load_dwordx4 v[96:99], v9, s[8:11], 0 offen offset:2048 nt
    buffer_load_dwordx4 v[100:103], v9, s[8:11], 0 offen offset:3072 nt
    v_add_u32 v9, s30, v9
    buffer_load_dwordx4 v[104:107], v9, s[8:11], 0 offen offset:0 nt
    buffer_load_dwordx4 v[108:111], v9, s[8:11], 0 offen offset:1024 nt
    buffer_load_dwordx4 v[112:115], v9, s[8:11], 0 offen offset:2048 nt
    buffer_load_dwordx4 v[116:119], v9, s[8:11], 0 offen offset:3072 nt
    v_add_u32 v9, s30, v9
    s_load_dwordx8 s[32:39], s[0:1], 16
    s_lshr_b32 s20, s20, 6
    s_lshr_b32 s16, s21, 21
    s_bfe_u32 s17, s21, 0x30012
    v_lshrrev_b32 v2, 6, v0
    v_and_b32 v1, 63, v0
    v_lshlrev_b32 v20, 4, v5
    v_add_u32 v20, 69632, v20
    v_lshl_add_u32 v19, v2, 2, v20
    v_lshlrev_b32 v10, 4, v1
    v_lshl_add_u32 v14, v2, 14, v10
    v_add_u32 v16, 65536, v10
    v_lshl_add_u32 v15, v2, 10, v16
    s_lshr_b32 s23, s21, 7
    v_add_u32 v6, s23, v10
    v_lshl_add_u32 v10, v2, 12, v10
    v_add_u32 v10, s21, v10
    v_lshrrev_b32 v5, 5, v1
    v_lshl_add_u32 v7, v5, 3, s23
    v_lshlrev_b32 v18, 4, v5
    v_add_u32 v18, 69632, v18
    v_lshl_add_u32 v17, v2, 2, v18
    s_lshl_b32 s28, s16, 2
    v_mov_b32 v12, s28
    v_mov_b32 v13, 1
    v_mov_b32 v22, 69696
    s_getreg_b32 s18, hwreg(HW_REG_XCC_ID, 0, 4)
    s_or_b32 s18, s18, 0x100
    s_cmp_eq_u32 s17, 0
    s_cselect_b32 s24, 2, -1
    v_mov_b32 v26, 0
    v_mov_b32 v27, 0
    ds_write_b64 v22, v[26:27]
    s_cselect_b32 s28, 1, s20
    s_cmp_eq_u32 s28, 0
    s_cselect_b32 s14, 8, -1
    s_cselect_b32 s15, 4, -1
    v_mov_b32 v3, 0x3e0293ee
    v_and_b32 v4, 1, v1
    v_lshlrev_b32 v4, 4, v4
    v_mov_b32 v5, 0xffff
    v_lshlrev_b32 v4, v4, v5
    v_bfe_u32 v5, v1, 1, 2
    v_cmp_eq_u32 vcc, 0, v5
    s_nop 1
    v_cndmask_b32 v32, 0, v4, vcc
    v_cmp_eq_u32 vcc, 1, v5
    s_nop 1
    v_cndmask_b32 v33, 0, v4, vcc
    v_cmp_eq_u32 vcc, 2, v5
    s_nop 1
    v_cndmask_b32 v34, 0, v4, vcc
    v_cmp_eq_u32 vcc, 3, v5
    s_nop 1
    v_cndmask_b32 v35, 0, v4, vcc
    v_mov_b32 v52, 0
    v_mov_b32 v56, 0
    v_mov_b32 v60, 0x3f803f80
    v_mov_b32 v53, 0
    v_mov_b32 v57, 0
    v_mov_b32 v61, 0x3f803f80
    v_mov_b32 v54, 0
    v_mov_b32 v58, 0
    v_mov_b32 v62, 0x3f803f80
    v_mov_b32 v55, 0
    v_mov_b32 v59, 0
    v_mov_b32 v63, 0x3f803f80
    v_mov_b32 v21, 0xff7fffff
    s_mov_b32 s25, 0
    s_waitcnt lgkmcnt(0)
L_k:
    s_cmp_lg_u32 s25, 14
    s_cbranch_scc1 L_ksw
    s_mov_b64 s[8:9], s[32:33]
    v_mov_b32 v9, v10
L_ksw:
    s_waitcnt vmcnt(7)
    v_mfma_f32_16x16x32_bf16 v[72:75], v[88:91], v[28:31], 0
    buffer_load_dwordx4 v[88:91], v9, s[8:11], 0 offen offset:0 nt
    s_waitcnt vmcnt(7)
    v_mfma_f32_16x16x32_bf16 v[76:79], v[92:95], v[28:31], 0
    buffer_load_dwordx4 v[92:95], v9, s[8:11], 0 offen offset:1024 nt
    s_waitcnt vmcnt(7)
    v_mfma_f32_16x16x32_bf16 v[80:83], v[96:99], v[28:31], 0
    buffer_load_dwordx4 v[96:99], v9, s[8:11], 0 offen offset:2048 nt
    s_waitcnt vmcnt(7)
    v_mfma_f32_16x16x32_bf16 v[84:87], v[100:103], v[28:31], 0
    buffer_load_dwordx4 v[100:103], v9, s[8:11], 0 offen offset:3072 nt
    v_add_u32 v9, s30, v9
    s_nop 2
    v_mul_f32_dpp v64, v72, v3 quad_perm:[0,0,0,0] row_mask:0xf bank_mask:0xf
    v_mul_f32_dpp v65, v76, v3 quad_perm:[0,0,0,0] row_mask:0xf bank_mask:0xf
    v_mul_f32_dpp v66, v80, v3 quad_perm:[0,0,0,0] row_mask:0xf bank_mask:0xf
    v_mul_f32_dpp v67, v84, v3 quad_perm:[0,0,0,0] row_mask:0xf bank_mask:0xf
    v_fmac_f32_dpp v64, v73, v3 quad_perm:[1,1,1,1] row_mask:0xf bank_mask:0xf
    v_fmac_f32_dpp v65, v77, v3 quad_perm:[1,1,1,1] row_mask:0xf bank_mask:0xf
    v_fmac_f32_dpp v66, v81, v3 quad_perm:[1,1,1,1] row_mask:0xf bank_mask:0xf
    v_fmac_f32_dpp v67, v85, v3 quad_perm:[1,1,1,1] row_mask:0xf bank_mask:0xf
    v_fmac_f32_dpp v64, v74, v3 quad_perm:[2,2,2,2] row_mask:0xf bank_mask:0xf
    v_fmac_f32_dpp v65, v78, v3 quad_perm:[2,2,2,2] row_mask:0xf bank_mask:0xf
    v_fmac_f32_dpp v66, v82, v3 quad_perm:[2,2,2,2] row_mask:0xf bank_mask:0xf
    v_fmac_f32_dpp v67, v86, v3 quad_perm:[2,2,2,2] row_mask:0xf bank_mask:0xf
    v_fmac_f32_dpp v64, v75, v3 quad_perm:[3,3,3,3] row_mask:0xf bank_mask:0xf
    v_fmac_f32_dpp v65, v79, v3 quad_perm:[3,3,3,3] row_mask:0xf bank_mask:0xf
    v_fmac_f32_dpp v66, v83, v3 quad_perm:[3,3,3,3] row_mask:0xf bank_mask:0xf
    v_fmac_f32_dpp v67, v87, v3 quad_perm:[3,3,3,3] row_mask:0xf bank_mask:0xf
    v_max3_f32 v21, v21, v64, v65
    ds_write_b128 v14, v[64:67]
    v_max3_f32 v21, v21, v66, v67
    v_add_u32 v14, 1024, v14
    s_add_u32 s25, s25, 1
    s_waitcnt vmcnt(7)
    v_mfma_f32_16x16x32_bf16 v[72:75], v[104:107], v[28:31], 0
    buffer_load_dwordx4 v[104:107], v9, s[8:11], 0 offen offset:0 nt
    s_waitcnt vmcnt(7)
    v_mfma_f32_16x16x32_bf16 v[76:79], v[108:111], v[28:31], 0
    buffer_load_dwordx4 v[108:111], v9, s[8:11], 0 offen offset:1024 nt
    s_waitcnt vmcnt(7)
    v_mfma_f32_16x16x32_bf16 v[80:83], v[112:115], v[28:31], 0
    buffer_load_dwordx4 v[112:115], v9, s[8:11], 0 offen offset:2048 nt
    s_waitcnt vmcnt(7)
    v_mfma_f32_16x16x32_bf16 v[84:87], v[116:119], v[28:31], 0
    buffer_load_dwordx4 v[116:119], v9, s[8:11], 0 offen offset:3072 nt
    v_add_u32 v9, s30, v9
    s_nop 2
    v_mul_f32_dpp v64, v72, v3 quad_perm:[0,0,0,0] row_mask:0xf bank_mask:0xf
    v_mul_f32_dpp v65, v76, v3 quad_perm:[0,0,0,0] row_mask:0xf bank_mask:0xf
    v_mul_f32_dpp v66, v80, v3 quad_perm:[0,0,0,0] row_mask:0xf bank_mask:0xf
    v_mul_f32_dpp v67, v84, v3 quad_perm:[0,0,0,0] row_mask:0xf bank_mask:0xf
    v_fmac_f32_dpp v64, v73, v3 quad_perm:[1,1,1,1] row_mask:0xf bank_mask:0xf
    v_fmac_f32_dpp v65, v77, v3 quad_perm:[1,1,1,1] row_mask:0xf bank_mask:0xf
    v_fmac_f32_dpp v66, v81, v3 quad_perm:[1,1,1,1] row_mask:0xf bank_mask:0xf
    v_fmac_f32_dpp v67, v85, v3 quad_perm:[1,1,1,1] row_mask:0xf bank_mask:0xf
    v_fmac_f32_dpp v64, v74, v3 quad_perm:[2,2,2,2] row_mask:0xf bank_mask:0xf
    v_fmac_f32_dpp v65, v78, v3 quad_perm:[2,2,2,2] row_mask:0xf bank_mask:0xf
    v_fmac_f32_dpp v66, v82, v3 quad_perm:[2,2,2,2] row_mask:0xf bank_mask:0xf
    v_fmac_f32_dpp v67, v86, v3 quad_perm:[2,2,2,2] row_mask:0xf bank_mask:0xf
    v_fmac_f32_dpp v64, v75, v3 quad_perm:[3,3,3,3] row_mask:0xf bank_mask:0xf
    v_fmac_f32_dpp v65, v79, v3 quad_perm:[3,3,3,3] row_mask:0xf bank_mask:0xf
    v_fmac_f32_dpp v66, v83, v3 quad_perm:[3,3,3,3] row_mask:0xf bank_mask:0xf
    v_fmac_f32_dpp v67, v87, v3 quad_perm:[3,3,3,3] row_mask:0xf bank_mask:0xf
    v_max3_f32 v21, v21, v64, v65
    ds_write_b128 v14, v[64:67]
    v_max3_f32 v21, v21, v66, v67
    v_add_u32 v14, 1024, v14
    s_add_u32 s25, s25, 1
    s_cmp_lg_u32 s25, 16
    s_cbranch_scc1 L_k
    v_subrev_u32 v14, 16384, v14
    v_mov_b32 v4, v21
    s_nop 1
    v_permlane16_swap_b32 v21, v4
    s_nop 0
    v_max_f32 v21, v21, v4
    v_mov_b32 v4, v21
    s_nop 1
    v_permlane32_swap_b32 v21, v4
    s_nop 0
    v_max_f32 v21, v21, v4
    ds_write_b32 v19, v21
    s_waitcnt lgkmcnt(0)
    s_barrier
    ds_read_b128 v[72:75], v20
    ds_read_b128 v[80:83], v18
    ds_read_b128 v[68:71], v14
    s_waitcnt lgkmcnt(1)
    v_max3_f32 v21, v72, v73, v74
    v_max_f32 v21, v21, v75
    v_max3_f32 v26, v80, v81, v82
    v_max_f32 v26, v26, v83
    v_min_u32 v26, -2, v26
    s_mov_b32 s25, 16
L_v:
    s_cmp_lg_u32 s25, s24
    s_cbranch_scc1 L_notrig
    s_barrier
L_notrig:
    s_cmp_lg_u32 s25, s14
    s_cbranch_scc1 L_nf1
    global_load_dword v11, v12, s[36:37] sc1
L_nf1:
    s_cmp_lg_u32 s25, s15
    s_cbranch_scc1 L_nf2
    ds_write_b32 v22, v11 offset:4
L_nf2:
    s_waitcnt lgkmcnt(0)
    v_sub_f32 v64, v68, v21
    v_sub_f32 v65, v69, v21
    v_sub_f32 v66, v70, v21
    v_sub_f32 v67, v71, v21
    ds_read_b128 v[68:71], v14 offset:1024
    v_add_u32 v14, 1024, v14
    v_exp_f32 v64, v64
    v_exp_f32 v65, v65
    v_exp_f32 v66, v66
    v_exp_f32 v67, v67
    s_sub_u32 s25, s25, 1
    v_cvt_pk_bf16_f32 v64, v64, v64
    v_cvt_pk_bf16_f32 v65, v65, v65
    v_cvt_pk_bf16_f32 v66, v66, v66
    v_cvt_pk_bf16_f32 v67, v67, v67
    v_and_b32 v36, v64, v32
    v_and_b32 v37, v64, v33
    v_and_b32 v38, v64, v34
    v_and_b32 v39, v64, v35
    v_and_b32 v40, v65, v32
    v_and_b32 v41, v65, v33
    v_and_b32 v42, v65, v34
    v_and_b32 v43, v65, v35
    v_and_b32 v44, v66, v32
    v_and_b32 v45, v66, v33
    v_and_b32 v46, v66, v34
    v_and_b32 v47, v66, v35
    v_and_b32 v48, v67, v32
    v_and_b32 v49, v67, v33
    v_and_b32 v50, v67, v34
    v_and_b32 v51, v67, v35
    v_mfma_f32_16x16x32_bf16 v[56:59], v[36:39], v[60:63], v[56:59]
    v_mfma_f32_16x16x32_bf16 v[56:59], v[40:43], v[60:63], v[56:59]
    v_mfma_f32_16x16x32_bf16 v[56:59], v[44:47], v[60:63], v[56:59]
    v_mfma_f32_16x16x32_bf16 v[56:59], v[48:51], v[60:63], v[56:59]
    s_waitcnt vmcnt(7)
    v_mfma_f32_16x16x32_bf16 v[52:55], v[36:39], v[88:91], v[52:55]
    buffer_load_dwordx4 v[88:91], v9, s[8:11], 0 offen offset:0 nt
    s_waitcnt vmcnt(7)
    v_mfma_f32_16x16x32_bf16 v[52:55], v[40:43], v[92:95], v[52:55]
    buffer_load_dwordx4 v[92:95], v9, s[8:11], 0 offen offset:1024 nt
    s_waitcnt vmcnt(7)
    v_mfma_f32_16x16x32_bf16 v[52:55], v[44:47], v[96:99], v[52:55]
    buffer_load_dwordx4 v[96:99], v9, s[8:11], 0 offen offset:2048 nt
    s_waitcnt vmcnt(7)
    v_mfma_f32_16x16x32_bf16 v[52:55], v[48:51], v[100:103], v[52:55]
    buffer_load_dwordx4 v[100:103], v9, s[8:11], 0 offen offset:3072 nt
    v_add_u32 v9, s30, v9
    s_waitcnt lgkmcnt(0)
    v_sub_f32 v64, v68, v21
    v_sub_f32 v65, v69, v21
    v_sub_f32 v66, v70, v21
    v_sub_f32 v67, v71, v21
    ds_read_b128 v[68:71], v14 offset:1024
    v_add_u32 v14, 1024, v14
    v_exp_f32 v64, v64
    v_exp_f32 v65, v65
    v_exp_f32 v66, v66
    v_exp_f32 v67, v67
    s_sub_u32 s25, s25, 1
    v_cvt_pk_bf16_f32 v64, v64, v64
    v_cvt_pk_bf16_f32 v65, v65, v65
    v_cvt_pk_bf16_f32 v66, v66, v66
    v_cvt_pk_bf16_f32 v67, v67, v67
    v_and_b32 v36, v64, v32
    v_and_b32 v37, v64, v33
    v_and_b32 v38, v64, v34
    v_and_b32 v39, v64, v35
    v_and_b32 v40, v65, v32
    v_and_b32 v41, v65, v33
    v_and_b32 v42, v65, v34
    v_and_b32 v43, v65, v35
    v_and_b32 v44, v66, v32
    v_and_b32 v45, v66, v33
    v_and_b32 v46, v66, v34
    v_and_b32 v47, v66, v35
    v_and_b32 v48, v67, v32
    v_and_b32 v49, v67, v33
    v_and_b32 v50, v67, v34
    v_and_b32 v51, v67, v35
    v_mfma_f32_16x16x32_bf16 v[56:59], v[36:39], v[60:63], v[56:59]
    v_mfma_f32_16x16x32_bf16 v[56:59], v[40:43], v[60:63], v[56:59]
    v_mfma_f32_16x16x32_bf16 v[56:59], v[44:47], v[60:63], v[56:59]
    v_mfma_f32_16x16x32_bf16 v[56:59], v[48:51], v[60:63], v[56:59]
    s_cmp_eq_u32 s25, 0
    s_waitcnt vmcnt(7)
    v_mfma_f32_16x16x32_bf16 v[52:55], v[36:39], v[104:107], v[52:55]
    buffer_load_dwordx4 v[104:107], v9, s[8:11], 0 offen offset:0 nt
    s_waitcnt vmcnt(7)
    v_mfma_f32_16x16x32_bf16 v[52:55], v[40:43], v[108:111], v[52:55]
    buffer_load_dwordx4 v[108:111], v9, s[8:11], 0 offen offset:1024 nt
    s_waitcnt vmcnt(7)
    v_mfma_f32_16x16x32_bf16 v[52:55], v[44:47], v[112:115], v[52:55]
    buffer_load_dwordx4 v[112:115], v9, s[8:11], 0 offen offset:2048 nt
    s_waitcnt vmcnt(7)
    v_mfma_f32_16x16x32_bf16 v[52:55], v[48:51], v[116:119], v[52:55]
    s_cbranch_scc1 L_vx
    buffer_load_dwordx4 v[116:119], v9, s[8:11], 0 offen offset:3072 nt
    v_add_u32 v9, s30, v9
    s_branch L_v
L_vx:
    ds_write_b32 v17, v56 offset:32
    s_nop 5
    ds_write_b128 v15, v[52:55]
    s_mov_b64 exec, 1
    ds_add_rtn_u32 v24, v22, v13
    s_mov_b64 exec, -1
    ds_read_b128 v[124:127], v16 offset:0
    ds_read_b128 v[128:131], v16 offset:1024
    ds_read_b128 v[132:135], v16 offset:2048
    ds_read_b128 v[136:139], v16 offset:3072
    ds_read_b128 v[120:123], v18 offset:32
    ds_read_b32 v11, v22 offset:4
    s_waitcnt lgkmcnt(6)
    v_readfirstlane_b32 s28, v24
    s_cmp_lg_u32 s28, 3
    s_cbranch_scc1 L_end
    s_waitcnt lgkmcnt(4)
    v_pk_add_f32 v[52:53], v[124:125], v[128:129]
    v_pk_add_f32 v[54:55], v[126:127], v[130:131]
    s_waitcnt lgkmcnt(3)
    v_pk_add_f32 v[52:53], v[52:53], v[132:133]
    v_pk_add_f32 v[54:55], v[54:55], v[134:135]
    s_waitcnt lgkmcnt(2)
    v_pk_add_f32 v[52:53], v[52:53], v[136:137]
    v_pk_add_f32 v[54:55], v[54:55], v[138:139]
    s_waitcnt lgkmcnt(0)
    v_cmp_ne_u32 vcc, s18, v11
    v_min_u32 v52, -2, v52
    v_min_u32 v53, -2, v53
    v_min_u32 v54, -2, v54
    v_min_u32 v55, -2, v55
    v_add_f32 v27, v120, v121
    v_add_f32 v27, v27, v122
    v_add_f32 v27, v27, v123
    v_min_u32 v27, -2, v27
    s_cbranch_vccnz L_far
    global_store_dwordx4 v6, v[52:55], s[38:39]
    global_store_dwordx2 v7, v[26:27], s[38:39] offset:1024
    s_endpgm
L_far:
    v_add_u32 v6, 524288, v6
    v_add_u32 v7, 524288, v7
    global_store_dwordx4 v6, v[52:55], s[38:39] sc1
    global_store_dwordx2 v7, v[26:27], s[38:39] offset:1024 sc1
    s_lshl_b32 s28, 1, s17
    v_mov_b32 v5, s28
    s_waitcnt vmcnt(0)
    s_mov_b64 exec, 1
    global_atomic_or v12, v5, s[36:37] offset:128 sc1
    s_endpgm
L_helper:
    s_bfe_u32 s17, s21, 0x30012
    s_cbranch_scc1 L_end
    s_load_dwordx8 s[32:39], s[0:1], 16
    s_lshr_b32 s16, s21, 21
    s_lshl_b32 s19, s16, 9
    v_and_b32 v1, 63, v0
    s_lshl_b32 s28, s16, 2
    v_mov_b32 v12, s28
    v_mov_b32 v22, 69696
    s_lshr_b32 s23, s21, 7
    v_lshl_add_u32 v6, v1, 4, s23
    v_add_u32 v6, 4096, v6
    v_add_u32 v8, 8192, v6
    v_lshrrev_b32 v5, 5, v1
    v_lshl_add_u32 v18, v5, 3, s23
    v_and_b32 v4, 7, v1
    v_lshl_add_u32 v7, v4, 11, v18
    v_mov_b32 v36, -1
    v_mov_b32 v37, -1
    v_mov_b32 v38, -1
    v_mov_b32 v39, -1
    v_lshlrev_b32 v23, 8, v5
    v_and_b32 v4, 15, v1
    v_lshl_add_u32 v23, v4, 4, v23
    v_bfe_u32 v4, v1, 4, 1
    v_lshl_add_u32 v23, v4, 3, v23
    v_add_u32 v23, s19, v23
    s_getreg_b32 s18, hwreg(HW_REG_XCC_ID, 0, 4)
    s_or_b32 s18, s18, 0x100
    v_mov_b32 v27, s18
    s_mov_b32 s27, 0x100000
    s_mov_b32 s26, 0
    s_waitcnt lgkmcnt(0)
    s_add_u32 s12, s38, 524288
    s_addc_u32 s13, s39, 0
    s_barrier
    global_store_dwordx2 v7, v[36:37], s[38:39] offset:1024
    global_store_dwordx4 v6, v[36:39], s[38:39] offset:-4096
    global_store_dwordx4 v6, v[36:39], s[38:39] offset:-2048
    global_store_dwordx4 v6, v[36:39], s[38:39] offset:0
    global_store_dwordx4 v6, v[36:39], s[38:39] offset:2048
    global_store_dwordx4 v8, v[36:39], s[38:39] offset:-4096
    global_store_dwordx4 v8, v[36:39], s[38:39] offset:-2048
    global_store_dwordx4 v8, v[36:39], s[38:39] offset:0
    global_store_dwordx4 v8, v[36:39], s[38:39] offset:2048
    s_waitcnt vmcnt(0)
    global_store_dword v12, v27, s[36:37] sc1
    ds_write_b32 v22, v27 offset:4
    s_waitcnt lgkmcnt(0)
    s_barrier
L_poll:
    global_load_dwordx2 v[152:153], v7, s[38:39] offset:1024 sc1
    global_load_dwordx4 v[120:123], v6, s[38:39] offset:-4096 sc1
    global_load_dwordx4 v[124:127], v6, s[38:39] offset:-2048 sc1
    global_load_dwordx4 v[128:131], v6, s[38:39] offset:0 sc1
    global_load_dwordx4 v[132:135], v6, s[38:39] offset:2048 sc1
    global_load_dwordx4 v[136:139], v8, s[38:39] offset:-4096 sc1
    global_load_dwordx4 v[140:143], v8, s[38:39] offset:-2048 sc1
    global_load_dwordx4 v[144:147], v8, s[38:39] offset:0 sc1
    global_load_dwordx4 v[148:151], v8, s[38:39] offset:2048 sc1
    s_waitcnt vmcnt(8)
    v_max_f32_dpp v161, v152, v152 quad_perm:[1,0,3,2] row_mask:0xf bank_mask:0xf
    v_max_u32 v160, v152, v153
    s_waitcnt vmcnt(7)
    v_max_f32_dpp v161, v161, v161 quad_perm:[2,3,0,1] row_mask:0xf bank_mask:0xf
    v_max3_u32 v160, v160, v120, v121
    v_max3_u32 v160, v160, v122, v123
    v_max_f32_dpp v161, v161, v161 row_half_mirror row_mask:0xf bank_mask:0xf
    v_sub_f32 v161, v152, v161
    v_exp_f32 v161, v161
    s_waitcnt vmcnt(6)
    v_mul_f32 v162, v161, v153
    v_max3_u32 v160, v160, v124, v125
    v_max3_u32 v160, v160, v126, v127
    v_mul_f32_dpp v156, v161, v120 row_newbcast:0 row_mask:0xf bank_mask:0xf
    v_mul_f32_dpp v157, v161, v121 row_newbcast:0 row_mask:0xf bank_mask:0xf
    v_mul_f32_dpp v158, v161, v122 row_newbcast:0 row_mask:0xf bank_mask:0xf
    v_mul_f32_dpp v159, v161, v123 row_newbcast:0 row_mask:0xf bank_mask:0xf
    v_add_f32_dpp v162, v162, v162 quad_perm:[1,0,3,2] row_mask:0xf bank_mask:0xf
    v_fmac_f32_dpp v156, v161, v124 row_newbcast:1 row_mask:0xf bank_mask:0xf
    v_fmac_f32_dpp v157, v161, v125 row_newbcast:1 row_mask:0xf bank_mask:0xf
    v_fmac_f32_dpp v158, v161, v126 row_newbcast:1 row_mask:0xf bank_mask:0xf
    v_fmac_f32_dpp v159, v161, v127 row_newbcast:1 row_mask:0xf bank_mask:0xf
    s_waitcnt vmcnt(5)
    v_add_f32_dpp v162, v162, v162 quad_perm:[2,3,0,1] row_mask:0xf bank_mask:0xf
    v_fmac_f32_dpp v156, v161, v128 row_newbcast:2 row_mask:0xf bank_mask:0xf
    v_fmac_f32_dpp v157, v161, v129 row_newbcast:2 row_mask:0xf bank_mask:0xf
    v_fmac_f32_dpp v158, v161, v130 row_newbcast:2 row_mask:0xf bank_mask:0xf
    v_fmac_f32_dpp v159, v161, v131 row_newbcast:2 row_mask:0xf bank_mask:0xf
    v_max3_u32 v160, v160, v128, v129
    v_max3_u32 v160, v160, v130, v131
    s_waitcnt vmcnt(4)
    v_add_f32_dpp v162, v162, v162 row_half_mirror row_mask:0xf bank_mask:0xf
    v_fmac_f32_dpp v156, v161, v132 row_newbcast:3 row_mask:0xf bank_mask:0xf
    v_fmac_f32_dpp v157, v161, v133 row_newbcast:3 row_mask:0xf bank_mask:0xf
    v_fmac_f32_dpp v158, v161, v134 row_newbcast:3 row_mask:0xf bank_mask:0xf
    v_fmac_f32_dpp v159, v161, v135 row_newbcast:3 row_mask:0xf bank_mask:0xf
    v_rcp_f32 v162, v162
    v_max3_u32 v160, v160, v132, v133
    v_max3_u32 v160, v160, v134, v135
    s_waitcnt vmcnt(3)
    v_fmac_f32_dpp v156, v161, v136 row_newbcast:4 row_mask:0xf bank_mask:0xf
    v_fmac_f32_dpp v157, v161, v137 row_newbcast:4 row_mask:0xf bank_mask:0xf
    v_fmac_f32_dpp v158, v161, v138 row_newbcast:4 row_mask:0xf bank_mask:0xf
    v_fmac_f32_dpp v159, v161, v139 row_newbcast:4 row_mask:0xf bank_mask:0xf
    v_max3_u32 v160, v160, v136, v137
    v_max3_u32 v160, v160, v138, v139
    s_waitcnt vmcnt(2)
    v_fmac_f32_dpp v156, v161, v140 row_newbcast:5 row_mask:0xf bank_mask:0xf
    v_fmac_f32_dpp v157, v161, v141 row_newbcast:5 row_mask:0xf bank_mask:0xf
    v_fmac_f32_dpp v158, v161, v142 row_newbcast:5 row_mask:0xf bank_mask:0xf
    v_fmac_f32_dpp v159, v161, v143 row_newbcast:5 row_mask:0xf bank_mask:0xf
    v_max3_u32 v160, v160, v140, v141
    v_max3_u32 v160, v160, v142, v143
    s_waitcnt vmcnt(1)
    v_fmac_f32_dpp v156, v161, v144 row_newbcast:6 row_mask:0xf bank_mask:0xf
    v_fmac_f32_dpp v157, v161, v145 row_newbcast:6 row_mask:0xf bank_mask:0xf
    v_fmac_f32_dpp v158, v161, v146 row_newbcast:6 row_mask:0xf bank_mask:0xf
    v_fmac_f32_dpp v159, v161, v147 row_newbcast:6 row_mask:0xf bank_mask:0xf
    v_max3_u32 v160, v160, v144, v145
    v_max3_u32 v160, v160, v146, v147
    s_waitcnt vmcnt(0)
    v_fmac_f32_dpp v156, v161, v148 row_newbcast:7 row_mask:0xf bank_mask:0xf
    v_fmac_f32_dpp v157, v161, v149 row_newbcast:7 row_mask:0xf bank_mask:0xf
    v_fmac_f32_dpp v158, v161, v150 row_newbcast:7 row_mask:0xf bank_mask:0xf
    v_fmac_f32_dpp v159, v161, v151 row_newbcast:7 row_mask:0xf bank_mask:0xf
    v_max3_u32 v160, v160, v148, v149
    v_max3_u32 v160, v160, v150, v151
    v_cmp_eq_u32 vcc, -1, v160
    v_mul_f32 v156, v162, v156
    v_mul_f32 v157, v162, v157
    v_mul_f32 v158, v162, v158
    v_mul_f32 v159, v162, v159
    v_cvt_pk_bf16_f32 v156, v156, v157
    v_cvt_pk_bf16_f32 v157, v158, v159
    s_cbranch_vccnz L_again
    global_store_dwordx2 v23, v[156:157], s[34:35]
    s_endpgm
L_again:
    s_sub_u32 s27, s27, 1
    s_cbranch_scc1 L_end
    s_cmp_gt_u32 s27, 1048564
    s_cbranch_scc1 L_poll
    global_load_dword v11, v12, s[36:37] offset:128 sc1
    s_waitcnt vmcnt(0)
    v_readfirstlane_b32 s28, v11
    s_andn2_b32 s28, s28, s26
    s_and_b32 s28, s28, 0xff
    s_cbranch_scc0 L_poll
    s_or_b32 s26, s26, s28
L_imp:
    s_ff1_i32_b32 s29, s28
    s_bitset0_b32 s28, s29
    s_lshl_b32 s29, s29, 11
    v_add_u32 v4, s29, v6
    v_add_u32 v5, s29, v18
    global_load_dwordx4 v[36:39], v4, s[12:13] offset:-4096 sc1
    global_load_dwordx2 v[26:27], v5, s[12:13] offset:1024 sc1
    s_waitcnt vmcnt(0)
    global_store_dwordx4 v4, v[36:39], s[38:39] offset:-4096
    global_store_dwordx2 v5, v[26:27], s[38:39] offset:1024
    s_waitcnt vmcnt(0)
    s_cmp_lg_u32 s28, 0
    s_cbranch_scc1 L_imp
    s_branch L_poll
L_end:
    s_endpgm
.section .rodata,"a"
.p2align 6
.amdhsa_kernel standalone__gqa_softmax__decode_kernel
  .amdhsa_next_free_vgpr 168
  .amdhsa_next_free_sgpr 48
  .amdhsa_accum_offset 168
  .amdhsa_group_segment_fixed_size 0
  .amdhsa_kernarg_size 48
  .amdhsa_user_sgpr_count 2
  .amdhsa_user_sgpr_kernarg_segment_ptr 1
  .amdhsa_system_sgpr_workgroup_id_x 1
.end_amdhsa_kernel
```
